```python
import torch

def _softmax(x, axis=-1):
    return torch.softmax(x, dim=axis)
def _gelu(x):
    return torch.nn.functional.gelu(x, approximate="tanh")
def _silu(x):
    return torch.nn.functional.silu(x)
def _sigmoid(x):
    return torch.sigmoid(x)
def _layernorm(x, axis=-1, eps=1e-5):
    m = x.mean(dim=axis, keepdim=True)
    v = x.var(dim=axis, keepdim=True, unbiased=False)
    return (x - m) / torch.sqrt(v + eps)
def _scatter_add(tgt, idx, src, axis=0):
    return tgt.clone().index_add_(axis, idx, src)
def _segment_sum(src, seg, n):
    out = torch.zeros((n,) + src.shape[1:], dtype=src.dtype)
    return out.index_add_(0, seg, src)
def _pad(x, pw):
    flat = tuple(v for pair in reversed(pw) for v in pair)
    return torch.nn.functional.pad(x, flat)

kernel_name = 'parallel_sum__sliding_block_cached__mixer_channel_mlp__decode'

def setup_inputs():

    _w = (lambda a: (lambda t: t.to(torch.bfloat16) if t.is_floating_point() else t)(torch.as_tensor(a)))
    def _A_setup():
        B, Sq, D = 1, 1, 448
        Hq, Hkv, Sk, Dh = 16, 8, 8192, 256
        assert Hq % Hkv == 0, (Hq, Hkv)
        return {
            "x": _w((lambda *s: torch.randn(*s, dtype=torch.bfloat16) * 0.05)(B, Sq, D)),
            "k_cache": _w((lambda *s: torch.randn(*s, dtype=torch.bfloat16) * 3.2)(B, Hkv, Sk, Dh)),
            "v_cache": _w((lambda *s: torch.randn(*s, dtype=torch.bfloat16) * 0.4)(B, Hkv, Sk, Dh)),
            "wq": _w((lambda *s: torch.randn(*s, dtype=torch.bfloat16) * 3.2)(D, Hq * Dh) * (D ** -0.5)),
            "wo": _w((lambda *s: torch.randn(*s, dtype=torch.bfloat16) * 0.4)(Hq * Dh, D) * ((Hq * Dh) ** -0.5)),
        }
    _A_in = _A_setup()

    def _B_setup():
        B, S, D, F = 1, 1, 448, 1792
        return {
            "x": _w((lambda *s: torch.randn(*s, dtype=torch.bfloat16) * 0.05)(B, S, D)),
            "w1": _w((lambda *s: torch.randn(*s, dtype=torch.bfloat16) * 3.2)(D, F) * (D ** -0.5)),
            "b1": _w((lambda *s: torch.randn(*s, dtype=torch.bfloat16) * 1.6)(F)),
            "w2": _w((lambda *s: torch.randn(*s, dtype=torch.bfloat16) * 0.05)(F, D) * (F ** -0.5)),
            "b2": _w((lambda *s: torch.randn(*s, dtype=torch.bfloat16) * 0.05)(D)),
        }
    _B_in = _B_setup()

    return {
        "A_x": _A_in["x"],
        "A_k_cache": _A_in["k_cache"],
        "A_v_cache": _A_in["v_cache"],
        "A_wq": _A_in["wq"],
        "A_wo": _A_in["wo"],
        "B_x": _B_in["x"],
        "B_w1": _B_in["w1"],
        "B_b1": _B_in["b1"],
        "B_w2": _B_in["w2"],
        "B_b2": _B_in["b2"],
    }

def reference(A_x, A_k_cache, A_v_cache, A_wq, A_wo, B_x, B_w1, B_b1, B_w2, B_b2):
    def _A_ref(x, k_cache, v_cache, wq, wo):
        B, Sq, D = x.shape
        Hq, Dh = 16, 256
        Hkv, Sk = k_cache.shape[1], k_cache.shape[2]
        W = min(4096, max(256, Sk // 4))
        rep = Hq // Hkv
        q = (lambda x, *d: x.permute(*d))((x @ wq).reshape(B, Sq, Hq, Dh), 0, 2, 1, 3)
        k = (lambda x, n, axis: torch.repeat_interleave(x, n, dim=axis))(k_cache[:, :, Sk - W:, :], rep, axis=1)
        v = (lambda x, n, axis: torch.repeat_interleave(x, n, dim=axis))(v_cache[:, :, Sk - W:, :], rep, axis=1)
        scores = torch.einsum("bhqd,bhkd->bhqk", q, k) * (Dh ** -0.5)
        p = _softmax(scores, axis=-1)
        o = torch.einsum("bhqk,bhkd->bhqd", p, v)
        return (lambda x, *d: x.permute(*d))(o, 0, 2, 1, 3).reshape(B, Sq, Hq * Dh) @ wo

    def _B_ref(x, w1, b1, w2, b2):
        y = _layernorm(x, axis=-1)
        h = _gelu(torch.einsum("bsd,df->bsf", y, w1) + b1)
        return torch.einsum("bsf,fd->bsd", h, w2) + b2

    x = A_x
    xn = _layernorm(x, axis=-1)
    return x + _A_ref(xn, A_k_cache, A_v_cache, A_wq, A_wo) + _B_ref(xn, B_w1, B_b1, B_w2, B_b2)
```

```asm
; @launch grid=(256,1,1) block=(384,1,1) lds=118784
.amdgcn_target "amdgcn-amd-amdhsa--gfx950"
.text
.globl parallel_sum__sliding_block_cached__mixer_channel_mlp__decode_kernel
.p2align 8
.type parallel_sum__sliding_block_cached__mixer_channel_mlp__decode_kernel,@function
parallel_sum__sliding_block_cached__mixer_channel_mlp__decode_kernel:
    s_cmp_ge_u32 s2, 256
    s_cbranch_scc1 L_end
    s_load_dwordx2 s[20:21], s[0:1], 24
    s_load_dwordx2 s[8:9], s[0:1], 0
    s_load_dwordx2 s[36:37], s[0:1], 96
    s_load_dwordx2 s[28:29], s[0:1], 48
    s_load_dwordx2 s[12:13], s[0:1], 8
    s_load_dwordx2 s[16:17], s[0:1], 16
    s_load_dwordx2 s[24:25], s[0:1], 32
    s_load_dwordx2 s[32:33], s[0:1], 64
    s_load_dwordx2 s[40:41], s[0:1], 80
    s_load_dwordx2 s[44:45], s[0:1], 56
    s_load_dwordx2 s[48:49], s[0:1], 72
    s_getpc_b64 s[6:7]
L_pc:
    s_lshr_b32 s5, s2, 3
    s_mul_i32 s4, s5, 6
    v_lshrrev_b32 v1, 6, v0
    v_and_b32 v0, 63, v0
    v_add_u32 v2, s4, v1
    v_readfirstlane_b32 s3, v1
    v_and_b32 v2, 15, v2
    v_lshlrev_b32 v3, 4, v0
    v_lshl_add_u32 v2, v2, 10, v3
    v_min_u32 v2, L_end-L_pc-16, v2
    global_load_dwordx4 v[164:167], v2, s[6:7]
    v_mov_b32 v2, 0
    v_mov_b32 v4, 0
    v_mov_b32 v5, 0
    v_mov_b32 v6, 0
    v_mov_b32 v7, 0
    ds_write_b128 v2, v[4:7]
    s_mov_b32 s10, 896
    s_mov_b32 s11, 0x20000
    s_mov_b32 s14, 0x2000000
    s_mov_b32 s15, 0x20000
    s_mov_b32 s18, 0x2000000
    s_mov_b32 s19, 0x20000
    s_mov_b32 s22, 3670016
    s_mov_b32 s23, 0x20000
    s_mov_b32 s26, 3670016
    s_mov_b32 s27, 0x20000
    s_mov_b32 s30, 1605632
    s_mov_b32 s31, 0x20000
    s_mov_b32 s34, 1605632
    s_mov_b32 s35, 0x20000
    s_mov_b32 s38, 0x10000000
    s_mov_b32 s39, 0x20000
    s_mov_b32 s42, 896
    s_mov_b32 s43, 0x20000
    s_mov_b32 s46, 3584
    s_mov_b32 s47, 0x20000
    s_mov_b32 s50, 896
    s_mov_b32 s51, 0x20000
    s_and_b32 s4, s2, 7
    v_lshrrev_b32 v9, 4, v0
    v_lshrrev_b32 v14, 3, v0
    v_lshlrev_b32 v15, 1, v9
    v_and_b32 v13, 7, v0
    v_xor_b32 v13, v13, v15
    v_lshlrev_b32 v13, 4, v13
    v_lshl_add_u32 v16, v14, 13, v13
    v_add_u32 v17, 64512, v16
    v_add_u32 v18, 129024, v16
    v_add_u32 v19, 193536, v16
    s_and_b32 s52, s5, 7
    s_lshr_b32 s53, s5, 3
    s_lshl_b32 s54, s4, 10
    s_lshl_b32 s52, s52, 7
    s_add_u32 s54, s54, s52
    s_mul_i32 s53, s53, 917504
    s_add_u32 s54, s54, s53
    s_mov_b32 m0, 10240
    s_waitcnt lgkmcnt(0)
    s_cmp_eq_u32 s3, 4
    s_cbranch_scc1 L_loader
    buffer_load_dwordx4 v[4:7], v3, s[8:11], 0 offen
    s_load_dword s61, s[36:37], 0
    s_barrier
    s_branch L_compute
L_loader:
    s_setprio 3
    buffer_load_dwordx4 v16, s[20:23], s54 offen offset:0 nt lds
    buffer_load_dwordx4 v17, s[20:23], s54 offen offset:1024 nt lds
    buffer_load_dwordx4 v18, s[20:23], s54 offen offset:2048 nt lds
    buffer_load_dwordx4 v19, s[20:23], s54 offen offset:3072 nt lds
    s_barrier
    v_mov_b32 v12, 1
    s_mov_b32 m0, 14336
    s_add_u32 s54, s54, 262144
    buffer_load_dwordx4 v16, s[20:23], s54 offen offset:0 nt lds
    buffer_load_dwordx4 v17, s[20:23], s54 offen offset:1024 nt lds
    buffer_load_dwordx4 v18, s[20:23], s54 offen offset:2048 nt lds
    buffer_load_dwordx4 v19, s[20:23], s54 offen offset:3072 nt lds
    s_mov_b32 m0, 18432
    s_add_u32 s54, s54, 262144
    buffer_load_dwordx4 v16, s[20:23], s54 offen offset:0 nt lds
    buffer_load_dwordx4 v17, s[20:23], s54 offen offset:1024 nt lds
    buffer_load_dwordx4 v18, s[20:23], s54 offen offset:2048 nt lds
    buffer_load_dwordx4 v19, s[20:23], s54 offen offset:3072 nt lds
    s_mov_b32 m0, 22528
    s_add_u32 s54, s54, 262144
    buffer_load_dwordx4 v16, s[20:23], s54 offen offset:0 nt lds
    buffer_load_dwordx4 v17, s[20:23], s54 offen offset:1024 nt lds
    v_lshrrev_b32 v6, 5, v0
    v_and_b32 v8, 31, v0
    v_xor_b32 v8, v8, v6
    v_lshlrev_b32 v8, 4, v8
    v_lshl_add_u32 v24, v6, 9, v8
    v_xor_b32 v25, 32, v24
    v_xor_b32 v26, 64, v24
    v_xor_b32 v27, 96, v24
    v_xor_b32 v28, 128, v24
    v_xor_b32 v29, 160, v24
    v_xor_b32 v30, 192, v24
    v_xor_b32 v31, 224, v24
    s_lshl_b32 s58, s4, 22
    s_lshl_b32 s52, s5, 15
    s_add_u32 s58, s58, s52
    s_add_u32 s58, s58, 3145728
    s_add_u32 s59, s5, s4
    v_lshl_add_u32 v32, v14, 9, v13
    v_add_u32 v32, 4096, v32
    v_subrev_u32 v33, 896, v32
    v_subrev_u32 v34, 1792, v32
    v_subrev_u32 v35, 2688, v32
    s_add_u32 s52, s59, 0
    s_and_b32 s52, s52, 3
    s_lshl_b32 s52, s52, 13
    s_add_u32 m0, s52, 53248
    s_add_u32 s54, s58, s52
    buffer_load_dwordx4 v24, s[12:15], s54 offen offset:0 nt lds
    buffer_load_dwordx4 v25, s[12:15], s54 offen offset:1024 nt lds
    buffer_load_dwordx4 v26, s[12:15], s54 offen offset:2048 nt lds
    buffer_load_dwordx4 v27, s[12:15], s54 offen offset:3072 nt lds
    s_add_u32 m0, s52, 57344
    s_add_u32 s54, s54, 4096
    s_waitcnt vmcnt(16)
    buffer_load_dwordx4 v28, s[12:15], s54 offen offset:0 nt lds
    buffer_load_dwordx4 v29, s[12:15], s54 offen offset:1024 nt lds
    buffer_load_dwordx4 v30, s[12:15], s54 offen offset:2048 nt lds
    buffer_load_dwordx4 v31, s[12:15], s54 offen offset:3072 nt lds
    s_add_u32 s52, s59, 1
    s_and_b32 s52, s52, 3
    s_lshl_b32 s52, s52, 13
    s_add_u32 m0, s52, 53248
    s_add_u32 s54, s58, s52
    s_waitcnt vmcnt(16)
    buffer_load_dwordx4 v24, s[12:15], s54 offen offset:0 nt lds
    buffer_load_dwordx4 v25, s[12:15], s54 offen offset:1024 nt lds
    buffer_load_dwordx4 v26, s[12:15], s54 offen offset:2048 nt lds
    buffer_load_dwordx4 v27, s[12:15], s54 offen offset:3072 nt lds
    s_add_u32 m0, s52, 57344
    s_add_u32 s54, s54, 4096
    s_waitcnt vmcnt(16)
    buffer_load_dwordx4 v28, s[12:15], s54 offen offset:0 nt lds
    buffer_load_dwordx4 v29, s[12:15], s54 offen offset:1024 nt lds
    buffer_load_dwordx4 v30, s[12:15], s54 offen offset:2048 nt lds
    buffer_load_dwordx4 v31, s[12:15], s54 offen offset:3072 nt lds
    s_add_u32 s52, s59, 2
    s_and_b32 s52, s52, 3
    s_lshl_b32 s52, s52, 13
    s_add_u32 m0, s52, 53248
    s_add_u32 s54, s58, s52
    s_waitcnt vmcnt(16)
    ds_write_b32 v2, v12
    v_add_u32 v12, 1, v12
    buffer_load_dwordx4 v24, s[12:15], s54 offen offset:0 nt lds
    buffer_load_dwordx4 v25, s[12:15], s54 offen offset:1024 nt lds
    buffer_load_dwordx4 v26, s[12:15], s54 offen offset:2048 nt lds
    buffer_load_dwordx4 v27, s[12:15], s54 offen offset:3072 nt lds
    s_add_u32 m0, s52, 57344
    s_add_u32 s54, s54, 4096
    s_waitcnt vmcnt(16)
    buffer_load_dwordx4 v28, s[12:15], s54 offen offset:0 nt lds
    buffer_load_dwordx4 v29, s[12:15], s54 offen offset:1024 nt lds
    buffer_load_dwordx4 v30, s[12:15], s54 offen offset:2048 nt lds
    buffer_load_dwordx4 v31, s[12:15], s54 offen offset:3072 nt lds
    s_add_u32 s52, s59, 3
    s_and_b32 s52, s52, 3
    s_lshl_b32 s52, s52, 13
    s_add_u32 m0, s52, 53248
    s_add_u32 s54, s58, s52
    s_waitcnt vmcnt(16)
    buffer_load_dwordx4 v24, s[12:15], s54 offen offset:0 nt lds
    buffer_load_dwordx4 v25, s[12:15], s54 offen offset:1024 nt lds
    buffer_load_dwordx4 v26, s[12:15], s54 offen offset:2048 nt lds
    buffer_load_dwordx4 v27, s[12:15], s54 offen offset:3072 nt lds
    s_add_u32 m0, s52, 57344
    s_add_u32 s54, s54, 4096
    s_waitcnt vmcnt(16)
    buffer_load_dwordx4 v28, s[12:15], s54 offen offset:0 nt lds
    buffer_load_dwordx4 v29, s[12:15], s54 offen offset:1024 nt lds
    buffer_load_dwordx4 v30, s[12:15], s54 offen offset:2048 nt lds
    buffer_load_dwordx4 v31, s[12:15], s54 offen offset:3072 nt lds
    v_and_b32 v6, 1, v9
    v_lshlrev_b32 v6, 1, v6
    v_and_b32 v8, 3, v0
    v_xor_b32 v8, v8, v6
    v_lshlrev_b32 v8, 4, v8
    v_lshrrev_b32 v6, 2, v0
    v_mul_u32_u24 v20, 3584, v6
    v_add_u32 v20, v20, v8
    v_add_u32 v21, 56320, v20
    v_add_u32 v22, 112640, v20
    v_add_u32 v23, 168960, v20
    s_lshr_b32 s52, s5, 2
    s_and_b32 s53, s5, 3
    s_mul_i32 s54, s4, 448
    s_lshl_b32 s52, s52, 6
    s_add_u32 s54, s54, s52
    s_mul_i32 s53, s53, 401408
    s_add_u32 s54, s54, s53
    s_cmp_ge_u32 s5, 28
    s_mov_b32 m0, 46080
    s_cselect_b32 s54, 0x7000000, s54
    s_waitcnt vmcnt(16)
    buffer_load_dwordx4 v20, s[28:31], s54 offen offset:0 nt lds
    buffer_load_dwordx4 v21, s[28:31], s54 offen offset:1024 nt lds
    buffer_load_dwordx4 v22, s[28:31], s54 offen offset:2048 nt lds
    buffer_load_dwordx4 v23, s[28:31], s54 offen offset:3072 nt lds
    s_mov_b32 m0, 50176
    s_add_u32 s54, s54, 229376
    s_waitcnt vmcnt(17)
    buffer_load_dwordx4 v20, s[28:31], s54 offen offset:0 nt lds
    buffer_load_dwordx4 v21, s[28:31], s54 offen offset:1024 nt lds
    buffer_load_dwordx4 v22, s[28:31], s54 offen offset:2048 nt lds
    s_sub_u32 s58, s58, 4096
    s_add_u32 s52, s59, 0
    s_and_b32 s52, s52, 7
    s_lshl_b32 s52, s52, 12
    s_add_u32 m0, s52, 86016
    s_add_u32 s54, s58, s52
    s_waitcnt vmcnt(16)
    buffer_load_dwordx4 v32, s[16:19], s54 offen offset:0 nt lds
    buffer_load_dwordx4 v33, s[16:19], s54 offen offset:1024 nt lds
    buffer_load_dwordx4 v34, s[16:19], s54 offen offset:2048 nt lds
    buffer_load_dwordx4 v35, s[16:19], s54 offen offset:3072 nt lds
    s_add_u32 s52, s59, 1
    s_and_b32 s52, s52, 7
    s_lshl_b32 s52, s52, 12
    s_add_u32 m0, s52, 86016
    s_add_u32 s54, s58, s52
    s_waitcnt vmcnt(16)
    buffer_load_dwordx4 v32, s[16:19], s54 offen offset:0 nt lds
    buffer_load_dwordx4 v33, s[16:19], s54 offen offset:1024 nt lds
    buffer_load_dwordx4 v34, s[16:19], s54 offen offset:2048 nt lds
    buffer_load_dwordx4 v35, s[16:19], s54 offen offset:3072 nt lds
    s_add_u32 s52, s59, 2
    s_and_b32 s52, s52, 7
    s_lshl_b32 s52, s52, 12
    s_add_u32 m0, s52, 86016
    s_add_u32 s54, s58, s52
    s_waitcnt vmcnt(16)
    buffer_load_dwordx4 v32, s[16:19], s54 offen offset:0 nt lds
    buffer_load_dwordx4 v33, s[16:19], s54 offen offset:1024 nt lds
    buffer_load_dwordx4 v34, s[16:19], s54 offen offset:2048 nt lds
    buffer_load_dwordx4 v35, s[16:19], s54 offen offset:3072 nt lds
    s_add_u32 s52, s59, 3
    s_and_b32 s52, s52, 7
    s_lshl_b32 s52, s52, 12
    s_add_u32 m0, s52, 86016
    s_add_u32 s54, s58, s52
    s_waitcnt vmcnt(19)
    ds_write_b32 v2, v12
    v_add_u32 v12, 1, v12
    s_waitcnt vmcnt(16)
    buffer_load_dwordx4 v32, s[16:19], s54 offen offset:0 nt lds
    buffer_load_dwordx4 v33, s[16:19], s54 offen offset:1024 nt lds
    buffer_load_dwordx4 v34, s[16:19], s54 offen offset:2048 nt lds
    buffer_load_dwordx4 v35, s[16:19], s54 offen offset:3072 nt lds
    s_add_u32 s52, s59, 4
    s_and_b32 s52, s52, 7
    s_lshl_b32 s52, s52, 12
    s_add_u32 m0, s52, 86016
    s_add_u32 s54, s58, s52
    s_waitcnt vmcnt(16)
    ds_write_b32 v2, v12
    v_add_u32 v12, 1, v12
    buffer_load_dwordx4 v32, s[16:19], s54 offen offset:0 nt lds
    buffer_load_dwordx4 v33, s[16:19], s54 offen offset:1024 nt lds
    buffer_load_dwordx4 v34, s[16:19], s54 offen offset:2048 nt lds
    buffer_load_dwordx4 v35, s[16:19], s54 offen offset:3072 nt lds
    s_add_u32 s52, s59, 5
    s_and_b32 s52, s52, 7
    s_lshl_b32 s52, s52, 12
    s_add_u32 m0, s52, 86016
    s_add_u32 s54, s58, s52
    s_waitcnt vmcnt(40)
    buffer_load_dwordx4 v32, s[16:19], s54 offen offset:0 nt lds
    buffer_load_dwordx4 v33, s[16:19], s54 offen offset:1024 nt lds
    buffer_load_dwordx4 v34, s[16:19], s54 offen offset:2048 nt lds
    buffer_load_dwordx4 v35, s[16:19], s54 offen offset:3072 nt lds
    s_add_u32 s52, s59, 6
    s_and_b32 s52, s52, 7
    s_lshl_b32 s52, s52, 12
    s_add_u32 m0, s52, 86016
    s_add_u32 s54, s58, s52
    s_waitcnt vmcnt(40)
    buffer_load_dwordx4 v32, s[16:19], s54 offen offset:0 nt lds
    buffer_load_dwordx4 v33, s[16:19], s54 offen offset:1024 nt lds
    buffer_load_dwordx4 v34, s[16:19], s54 offen offset:2048 nt lds
    buffer_load_dwordx4 v35, s[16:19], s54 offen offset:3072 nt lds
    s_add_u32 s52, s59, 7
    s_and_b32 s52, s52, 7
    s_lshl_b32 s52, s52, 12
    s_add_u32 m0, s52, 86016
    s_add_u32 s54, s58, s52
    s_waitcnt vmcnt(40)
    buffer_load_dwordx4 v32, s[16:19], s54 offen offset:0 nt lds
    buffer_load_dwordx4 v33, s[16:19], s54 offen offset:1024 nt lds
    buffer_load_dwordx4 v34, s[16:19], s54 offen offset:2048 nt lds
    buffer_load_dwordx4 v35, s[16:19], s54 offen offset:3072 nt lds
    s_lshl_b32 s54, s4, 9
    s_lshl_b32 s52, s5, 4
    s_add_u32 s54, s54, s52
    s_mov_b32 m0, 24576
    s_mul_i32 s54, s54, 896
    s_waitcnt vmcnt(8)
    s_waitcnt vmcnt(40)
    buffer_load_dwordx4 v3, s[24:27], s54 offen offset:0 nt lds
    buffer_load_dwordx4 v3, s[24:27], s54 offen offset:1024 nt lds
    buffer_load_dwordx4 v3, s[24:27], s54 offen offset:2048 nt lds
    buffer_load_dwordx4 v3, s[24:27], s54 offen offset:3072 nt lds
    s_mov_b32 m0, 28672
    s_add_u32 s54, s54, 4096
    s_waitcnt vmcnt(40)
    buffer_load_dwordx4 v3, s[24:27], s54 offen offset:0 nt lds
    buffer_load_dwordx4 v3, s[24:27], s54 offen offset:1024 nt lds
    buffer_load_dwordx4 v3, s[24:27], s54 offen offset:2048 nt lds
    buffer_load_dwordx4 v3, s[24:27], s54 offen offset:3072 nt lds
    s_mov_b32 m0, 32768
    s_add_u32 s54, s54, 4096
    s_waitcnt vmcnt(40)
    buffer_load_dwordx4 v3, s[24:27], s54 offen offset:0 nt lds
    buffer_load_dwordx4 v3, s[24:27], s54 offen offset:1024 nt lds
    buffer_load_dwordx4 v3, s[24:27], s54 offen offset:2048 nt lds
    buffer_load_dwordx4 v3, s[24:27], s54 offen offset:3072 nt lds
    s_mov_b32 m0, 36864
    s_add_u32 s54, s54, 4096
    s_waitcnt vmcnt(42)
    buffer_load_dwordx4 v3, s[24:27], s54 offen offset:0 nt lds
    buffer_load_dwordx4 v3, s[24:27], s54 offen offset:1024 nt lds
    s_mul_i32 s54, s4, 224
    s_lshl_b32 s52, s5, 3
    s_add_u32 s54, s54, s52
    s_mul_i32 s54, s54, 896
    s_cmp_ge_u32 s5, 28
    s_mov_b32 m0, 38912
    s_cselect_b32 s54, 0x7000000, s54
    s_waitcnt vmcnt(40)
    buffer_load_dwordx4 v3, s[32:35], s54 offen offset:0 nt lds
    buffer_load_dwordx4 v3, s[32:35], s54 offen offset:1024 nt lds
    buffer_load_dwordx4 v3, s[32:35], s54 offen offset:2048 nt lds
    buffer_load_dwordx4 v3, s[32:35], s54 offen offset:3072 nt lds
    s_mov_b32 m0, 43008
    s_add_u32 s54, s54, 4096
    s_waitcnt vmcnt(41)
    buffer_load_dwordx4 v3, s[32:35], s54 offen offset:0 nt lds
    buffer_load_dwordx4 v3, s[32:35], s54 offen offset:1024 nt lds
    buffer_load_dwordx4 v3, s[32:35], s54 offen offset:2048 nt lds
    s_waitcnt vmcnt(21)
    ds_write_b32 v2, v12
    v_add_u32 v12, 1, v12
    s_waitcnt vmcnt(0)
    ds_write_b32 v2, v12
    s_waitcnt lgkmcnt(0)
    s_endpgm
L_compute:
    v_and_b32 v8, 15, v0
    v_and_b32 v10, 3, v0
    v_bfe_u32 v11, v0, 2, 2
    v_and_b32 v12, 1, v9
    v_lshlrev_b32 v12, 1, v12
    v_lshrrev_b32 v13, 1, v11
    v_or_b32 v12, v12, v13
    v_lshl_add_u32 v13, v9, 2, v11
    v_lshlrev_b32 v14, 7, v13
    v_lshl_add_u32 v14, v12, 5, v14
    v_lshl_add_u32 v14, v10, 3, v14
    s_min_u32 s7, s3, 4
    s_lshl_b32 s7, s7, 10
    s_add_u32 s7, s7, 2048
    v_add_u32 v16, s7, v3
    s_mov_b32 s6, 0
    s_mov_b32 s62, 0xff
    s_mov_b32 s63, 0xffff0000
    s_mov_b32 s64, 991054117
    s_mov_b32 s65, 1035512379
    s_mov_b32 s66, -1
    s_mov_b32 s67, 0x00ffffff
    v_lshlrev_b32 v87, 4, v9
    v_mov_b32 v58, 0
    v_mov_b32 v59, 0
    v_mov_b32 v74, 0
    v_mov_b32 v75, 0
    s_mov_b32 s68, 0
    s_cmp_lt_u32 s3, 4
    s_cbranch_scc1 L_nohello
    s_waitcnt lgkmcnt(0)
    s_add_u32 s61, s61, 1
    v_bfe_u32 v48, v0, 1, 2
    v_lshlrev_b32 v48, 10, v48
    v_and_b32 v49, 1, v0
    v_lshl_add_u32 v48, v49, 4, v48
    s_lshl_b32 s53, s4, 12
    s_lshl_b32 s54, s5, 5
    s_add_u32 s53, s53, s54
    s_add_u32 s53, s53, 73728
    buffer_load_dwordx4 v[128:131], v48, s[36:39], s53 offen sc1
    s_waitcnt vmcnt(1)
    s_branch L_ln
L_nohello:
    s_lshl_b32 s53, s4, 13
    s_lshl_b32 s54, s3, 9
    s_add_u32 s53, s53, s54
    s_add_u32 s53, s53, 4096
    s_add_u32 s54, s53, 4096
    v_lshlrev_b32 v40, 3, v0
    buffer_load_dwordx2 v[186:187], v40, s[36:39], s53 offen sc1
    buffer_load_dwordx2 v[188:189], v40, s[36:39], s53 offen offset:2048 sc1
    buffer_load_dwordx2 v[190:191], v40, s[36:39], s54 offen sc1
    buffer_load_dwordx2 v[192:193], v40, s[36:39], s54 offen offset:2048 sc1
    s_lshl_b32 s53, s4, 16
    s_lshl_b32 s54, s5, 11
    s_add_u32 s53, s53, s54
    s_lshl_b32 s54, s3, 9
    s_add_u32 s53, s53, s54
    s_add_u32 s53, s53, 131072
    buffer_load_dwordx2 v[194:195], v40, s[36:39], s53 offen sc1
    s_lshl_b32 s53, s4, 10
    s_and_b32 s54, s3, 1
    s_lshl_b32 s54, s54, 9
    s_add_u32 s53, s53, s54
    s_add_u32 s53, s53, 106496
    buffer_load_dwordx2 v[196:197], v40, s[36:39], s53 offen sc1
    s_waitcnt vmcnt(6)
L_ln:
    v_lshlrev_b32 v24, 16, v4
    v_and_b32 v25, s63, v4
    v_lshlrev_b32 v26, 16, v5
    v_and_b32 v27, s63, v5
    v_lshlrev_b32 v28, 16, v6
    v_and_b32 v29, s63, v6
    v_lshlrev_b32 v30, 16, v7
    v_and_b32 v31, s63, v7
    v_add_f32 v32, v24, v25
    v_add_f32 v33, v26, v27
    v_add_f32 v34, v28, v29
    v_add_f32 v35, v30, v31
    v_add_f32 v32, v32, v33
    v_add_f32 v34, v34, v35
    v_add_f32 v32, v32, v34
    s_nop 1
    v_add_f32_dpp v32, v32, v32 quad_perm:[1,0,3,2] row_mask:0xf bank_mask:0xf
    s_nop 1
    v_add_f32_dpp v32, v32, v32 quad_perm:[2,3,0,1] row_mask:0xf bank_mask:0xf
    s_nop 1
    v_add_f32_dpp v32, v32, v32 row_ror:4 row_mask:0xf bank_mask:0xf
    s_nop 1
    v_add_f32_dpp v32, v32, v32 row_ror:8 row_mask:0xf bank_mask:0xf
    v_mov_b32 v33, v32
    s_nop 1
    v_permlane16_swap_b32 v32, v33
    v_add_f32 v32, v32, v33
    v_mov_b32 v33, v32
    s_nop 1
    v_permlane32_swap_b32 v32, v33
    v_add_f32 v32, v32, v33
    v_mul_f32 v32, s64, v32
    v_mov_b32 v34, 0
    v_cvt_pk_bf16_f32 v33, v32, v32
    v_and_b32 v33, s63, v33
    s_mov_b64 exec, s[66:67]
    v_sub_f32 v35, v24, v32
    v_fmac_f32 v34, v35, v35
    v_sub_f32 v35, v25, v32
    v_fmac_f32 v34, v35, v35
    v_sub_f32 v35, v26, v32
    v_fmac_f32 v34, v35, v35
    v_sub_f32 v35, v27, v32
    v_fmac_f32 v34, v35, v35
    v_sub_f32 v35, v28, v32
    v_fmac_f32 v34, v35, v35
    v_sub_f32 v35, v29, v32
    v_fmac_f32 v34, v35, v35
    v_sub_f32 v35, v30, v32
    v_fmac_f32 v34, v35, v35
    v_sub_f32 v35, v31, v32
    v_fmac_f32 v34, v35, v35
    s_mov_b64 exec, -1
    s_nop 1
    v_add_f32_dpp v34, v34, v34 quad_perm:[1,0,3,2] row_mask:0xf bank_mask:0xf
    s_nop 1
    v_add_f32_dpp v34, v34, v34 quad_perm:[2,3,0,1] row_mask:0xf bank_mask:0xf
    s_nop 1
    v_add_f32_dpp v34, v34, v34 row_ror:4 row_mask:0xf bank_mask:0xf
    s_nop 1
    v_add_f32_dpp v34, v34, v34 row_ror:8 row_mask:0xf bank_mask:0xf
    v_mov_b32 v35, v34
    s_nop 1
    v_permlane16_swap_b32 v34, v35
    v_add_f32 v34, v34, v35
    v_mov_b32 v35, v34
    s_nop 1
    v_permlane32_swap_b32 v34, v35
    v_add_f32 v34, v34, v35
    v_mul_f32 v34, s64, v34
    v_cvt_pk_bf16_f32 v34, v34, v34
    v_and_b32 v34, s63, v34
    v_add_f32 v34, 925353388, v34
    v_cvt_pk_bf16_f32 v34, v34, v34
    v_and_b32 v34, s63, v34
    v_sqrt_f32 v34, v34
    s_nop 0
    v_cvt_pk_bf16_f32 v34, v34, v34
    v_and_b32 v34, s63, v34
    v_rcp_f32 v35, v34
    v_sub_f32 v24, v24, v33
    v_sub_f32 v25, v25, v33
    v_cvt_pk_bf16_f32 v36, v24, v25
    v_lshlrev_b32 v24, 16, v36
    v_and_b32 v25, s63, v36
    v_mul_f32 v36, v24, v35
    v_mul_f32 v37, v25, v35
    v_fma_f32 v38, -v36, v34, v24
    v_fma_f32 v39, -v37, v34, v25
    v_fmac_f32 v36, v38, v35
    v_fmac_f32 v37, v39, v35
    v_cvt_pk_bf16_f32 v4, v36, v37
    v_sub_f32 v26, v26, v33
    v_sub_f32 v27, v27, v33
    v_cvt_pk_bf16_f32 v36, v26, v27
    v_lshlrev_b32 v26, 16, v36
    v_and_b32 v27, s63, v36
    v_mul_f32 v36, v26, v35
    v_mul_f32 v37, v27, v35
    v_fma_f32 v38, -v36, v34, v26
    v_fma_f32 v39, -v37, v34, v27
    v_fmac_f32 v36, v38, v35
    v_fmac_f32 v37, v39, v35
    v_cvt_pk_bf16_f32 v5, v36, v37
    v_sub_f32 v28, v28, v33
    v_sub_f32 v29, v29, v33
    v_cvt_pk_bf16_f32 v36, v28, v29
    v_lshlrev_b32 v28, 16, v36
    v_and_b32 v29, s63, v36
    v_mul_f32 v36, v28, v35
    v_mul_f32 v37, v29, v35
    v_fma_f32 v38, -v36, v34, v28
    v_fma_f32 v39, -v37, v34, v29
    v_fmac_f32 v36, v38, v35
    v_fmac_f32 v37, v39, v35
    v_cvt_pk_bf16_f32 v6, v36, v37
    v_sub_f32 v30, v30, v33
    v_sub_f32 v31, v31, v33
    v_cvt_pk_bf16_f32 v36, v30, v31
    v_lshlrev_b32 v30, 16, v36
    v_and_b32 v31, s63, v36
    v_mul_f32 v36, v30, v35
    v_mul_f32 v37, v31, v35
    v_fma_f32 v38, -v36, v34, v30
    v_fma_f32 v39, -v37, v34, v31
    v_fmac_f32 v36, v38, v35
    v_fmac_f32 v37, v39, v35
    v_cvt_pk_bf16_f32 v7, v36, v37
    s_mov_b64 exec, s[66:67]
    s_not_b64 exec, exec
    v_mov_b32 v4, 0
    v_mov_b32 v5, 0
    v_mov_b32 v6, 0
    v_mov_b32 v7, 0
    s_mov_b64 exec, -1
    s_cmp_lt_u32 s3, 4
    s_cbranch_scc1 L_cw
    s_add_u32 s68, s68, 1
    s_cmp_eq_u32 s68, 1
    s_cbranch_scc1 L_ln
    s_branch L_aux
L_cw:
    ds_write_b128 v16, v[4:7]
    s_lshr_b32 s53, s5, 3
    s_mul_i32 s53, s53, 224
    s_add_u32 s53, s53, s7
    v_lshl_add_u32 v41, v9, 3, s53
    ds_read2_b64 v[44:47], v41 offset0:0 offset1:4
    ds_read2_b64 v[48:51], v41 offset0:8 offset1:12
    ds_read2_b64 v[52:55], v41 offset0:16 offset1:20
    ds_read_b64 v[56:57], v41 offset:192
    s_lshl_b32 s53, s3, 5
    v_xor_b32 v42, s53, v14
    v_mov_b32 v172, 0x7ff00000
    v_mov_b32 v178, 0x7ff00000
    v_mov_b32 v184, 0x7ff00000
    s_lshl_b32 s57, s4, 13
    s_lshr_b32 s54, s5, 3
    s_lshl_b32 s54, s54, 11
    s_add_u32 s57, s57, s54
    s_and_b32 s54, s5, 7
    s_lshl_b32 s54, s54, 8
    s_add_u32 s57, s57, s54
    s_lshl_b32 s54, s3, 6
    s_add_u32 s57, s57, s54
    s_add_u32 s57, s57, 4096
    s_mov_b32 s54, 0x00010001
    s_mov_b32 s55, 0x00010001
L_lw_1:
    ds_read_b32 v40, v2 offset:0
    s_waitcnt lgkmcnt(0)
    v_readfirstlane_b32 s52, v40
    s_cmp_ge_u32 s52, 1
    s_cbranch_scc1 L_lw_1_ok
    s_branch L_lw_1
L_lw_1_ok:
    ds_read_b64_tr_b16 v[60:61], v42 offset:10240
    ds_read_b64_tr_b16 v[62:63], v42 offset:12288
    ds_read_b64_tr_b16 v[64:65], v42 offset:14336
    ds_read_b64_tr_b16 v[66:67], v42 offset:16384
    ds_read_b64_tr_b16 v[68:69], v42 offset:18432
    ds_read_b64_tr_b16 v[70:71], v42 offset:20480
    ds_read_b64_tr_b16 v[72:73], v42 offset:22528
    s_add_u32 s61, s61, 1
    s_and_b32 s60, s61, 0xff
    v_mov_b32 v43, s60
    s_lshr_b32 s60, s61, 8
    s_and_b32 s60, s60, 127
    s_lshl_b32 s60, s60, 20
    s_add_u32 s60, s60, 0x200000
    s_getreg_b32 s7, hwreg(HW_REG_XCC_ID)
    s_and_b32 s7, s7, 15
    s_lshl_b32 s7, s7, 24
    s_xor_b32 s7, s7, s61
    s_waitcnt lgkmcnt(5)
    v_mfma_f32_16x16x32_bf16 v[76:79], v[60:63], v[44:47], 0
    s_waitcnt lgkmcnt(3)
    v_mfma_f32_16x16x32_bf16 v[76:79], v[64:67], v[48:51], v[76:79]
    s_waitcnt lgkmcnt(1)
    v_mfma_f32_16x16x32_bf16 v[76:79], v[68:71], v[52:55], v[76:79]
    s_waitcnt lgkmcnt(0)
    v_mfma_f32_16x16x32_bf16 v[76:79], v[72:75], v[56:59], v[76:79]
    s_nop 7
    v_add_u32 v76, 0x80, v76
    v_add_u32 v77, 0x80, v77
    v_add_u32 v78, 0x80, v78
    v_add_u32 v79, 0x80, v79
    v_bfi_b32 v76, s62, v43, v76
    v_bfi_b32 v77, s62, v43, v77
    v_bfi_b32 v78, s62, v43, v78
    v_bfi_b32 v79, s62, v43, v79
    s_mov_b64 exec, s[54:55]
    buffer_store_dwordx4 v[76:79], v87, s[36:39], s57 offen
    s_add_u32 s57, s57, s60
    v_add_u32 v172, s57, v87
    s_mov_b64 exec, -1
    v_mov_b32 v168, v76
    v_mov_b32 v169, v77
    v_mov_b32 v170, v78
    v_mov_b32 v171, v79
    v_and_b32 v88, 3, v8
    v_xor_b32 v88, v88, v9
    v_lshlrev_b32 v88, 4, v88
    v_and_b32 v89, 12, v8
    v_lshl_add_u32 v88, v89, 4, v88
    v_lshl_add_u32 v88, v8, 9, v88
    s_lshl_b32 s53, s3, 13
    s_add_u32 s53, s53, 53248
    v_add_u32 v88, s53, v88
    v_xor_b32 v89, 64, v88
    v_xor_b32 v90, 0x80, v88
    v_xor_b32 v91, 0xc0, v88
    v_and_b32 v93, 1, v8
    v_lshlrev_b32 v92, 9, v93
    v_lshl_add_u32 v92, v9, 4, v92
    v_lshlrev_b32 v93, 7, v93
    v_lshl_add_u32 v93, v9, 4, v93
    s_lshr_b32 s53, s3, 1
    s_lshl_b32 s53, s53, 6
    s_and_b32 s54, s3, 1
    s_lshl_b32 s54, s54, 3
    s_add_u32 s53, s53, s54
    v_add_u32 v94, s53, v93
    s_lshl_b32 s53, s3, 8
    v_lshl_add_u32 v95, v0, 2, s53
    v_lshrrev_b32 v80, 1, v8
    v_cmp_eq_u32 vcc, 0, v80
    v_cmp_eq_u32 s[54:55], 1, v80
    v_cmp_eq_u32 s[56:57], 2, v80
    v_cndmask_b32 v160, 0, -1, vcc
    v_cmp_eq_u32 vcc, 3, v80
    v_cndmask_b32 v161, 0, -1, s[54:55]
    v_cndmask_b32 v162, 0, -1, s[56:57]
    v_cndmask_b32 v163, 0, -1, vcc
    s_lshl_b32 s53, s3, 10
    s_add_u32 s53, s53, 86016
    v_and_b32 v81, 0x3ff, v14
    v_lshrrev_b32 v82, 1, v9
    v_lshl_add_u32 v81, v82, 12, v81
    v_add_u32 v81, s53, v81
    v_xor_b32 v82, 32, v81
    v_xor_b32 v83, 64, v81
    v_xor_b32 v84, 0x60, v81
    v_and_b32 v85, 1, v8
    v_lshl_add_u32 v85, v85, 4, v80
    v_lshlrev_b32 v85, 11, v85
    v_lshl_add_u32 v85, v9, 4, v85
    s_lshl_b32 s53, s4, 16
    s_lshl_b32 s54, s3, 13
    s_add_u32 s53, s53, s54
    s_lshl_b32 s54, s5, 6
    s_add_u32 s53, s53, s54
    s_add_u32 s58, s53, 131072
    s_mov_b32 s59, 0
    s_lshl_b32 s53, s4, 13
    s_lshl_b32 s54, s3, 9
    s_add_u32 s53, s53, s54
    s_add_u32 s57, s53, 4096
    v_lshlrev_b32 v59, 3, v0
    s_mov_b32 s56, 0
    s_and_b32 s53, s59, 127
    s_cmp_eq_u32 s53, 127
    s_cselect_b32 s53, s60, 0
    s_add_u32 s53, s53, s57
    s_add_u32 s54, s53, 4096
    buffer_load_dwordx2 v[186:187], v59, s[36:39], s53 offen sc1
    buffer_load_dwordx2 v[188:189], v59, s[36:39], s53 offen offset:2048 sc1
    buffer_load_dwordx2 v[190:191], v59, s[36:39], s54 offen sc1
    buffer_load_dwordx2 v[192:193], v59, s[36:39], s54 offen offset:2048 sc1
    s_add_u32 s59, s59, 1
    s_sleep 10
L_qpoll:
    s_cmp_lt_u32 s59, 64
    s_cbranch_scc1 L_qnt
    s_bitcmp1_b32 s6, 0
    s_cbranch_scc1 L_fl0t
    s_bitset1_b32 s6, 0
    buffer_store_dwordx4 v[168:171], v172, s[36:39], 0 offen sc1
L_fl0t:
    s_waitcnt vmcnt(4)
L_qnt:
    s_cmp_lg_u32 s56, 0
    s_cbranch_scc1 L_nk
    ds_read_b32 v40, v2
    s_waitcnt lgkmcnt(0)
    v_readfirstlane_b32 s52, v40
    s_cmp_lt_u32 s52, 2
    s_cbranch_scc1 L_nk
L_krd:
    s_add_u32 s56, s56, 1
    ds_read_b128 v[96:99], v88 offset:0
    ds_read_b128 v[100:103], v89 offset:0
    ds_read_b128 v[104:107], v90 offset:0
    ds_read_b128 v[108:111], v91 offset:0
    ds_read_b128 v[112:115], v88 offset:256
    ds_read_b128 v[116:119], v89 offset:256
    ds_read_b128 v[120:123], v90 offset:256
    ds_read_b128 v[124:127], v91 offset:256
    s_cmp_gt_u32 s56, 1
    s_cbranch_scc1 L_kdone
L_nk:
    s_and_b32 s53, s59, 127
    s_cmp_eq_u32 s53, 127
    s_cselect_b32 s53, s60, 0
    s_add_u32 s53, s53, s57
    s_add_u32 s54, s53, 4096
    buffer_load_dwordx2 v[194:195], v59, s[36:39], s53 offen sc1
    buffer_load_dwordx2 v[196:197], v59, s[36:39], s53 offen offset:2048 sc1
    buffer_load_dwordx2 v[198:199], v59, s[36:39], s54 offen sc1
    buffer_load_dwordx2 v[200:201], v59, s[36:39], s54 offen offset:2048 sc1
    s_add_u32 s59, s59, 1
    s_waitcnt vmcnt(4)
    v_xor_b32 v60, v186, v43
    v_xor_b32 v61, v187, v43
    v_xor_b32 v62, v188, v43
    v_xor_b32 v63, v189, v43
    v_xor_b32 v64, v190, v43
    v_xor_b32 v65, v191, v43
    v_xor_b32 v66, v192, v43
    v_xor_b32 v67, v193, v43
    v_or3_b32 v44, v60, v61, v62
    v_or3_b32 v44, v44, v63, v64
    v_or3_b32 v44, v44, v65, v66
    v_or_b32 v44, v44, v67
    v_and_b32 v44, s62, v44
    v_cmp_eq_u32 vcc, 0, v44
    s_cmp_gt_u32 s59, 200000
    s_cbranch_scc1 L_qsum
    s_cmp_eq_u64 vcc, -1
    s_cbranch_scc1 L_qsum
    s_and_b32 s53, s59, 127
    s_cmp_eq_u32 s53, 127
    s_cselect_b32 s53, s60, 0
    s_add_u32 s53, s53, s57
    s_add_u32 s54, s53, 4096
    buffer_load_dwordx2 v[186:187], v59, s[36:39], s53 offen sc1
    buffer_load_dwordx2 v[188:189], v59, s[36:39], s53 offen offset:2048 sc1
    buffer_load_dwordx2 v[190:191], v59, s[36:39], s54 offen sc1
    buffer_load_dwordx2 v[192:193], v59, s[36:39], s54 offen offset:2048 sc1
    s_add_u32 s59, s59, 1
    s_waitcnt vmcnt(4)
    v_xor_b32 v60, v194, v43
    v_xor_b32 v61, v195, v43
    v_xor_b32 v62, v196, v43
    v_xor_b32 v63, v197, v43
    v_xor_b32 v64, v198, v43
    v_xor_b32 v65, v199, v43
    v_xor_b32 v66, v200, v43
    v_xor_b32 v67, v201, v43
    v_or3_b32 v44, v60, v61, v62
    v_or3_b32 v44, v44, v63, v64
    v_or3_b32 v44, v44, v65, v66
    v_or_b32 v44, v44, v67
    v_and_b32 v44, s62, v44
    v_cmp_eq_u32 vcc, 0, v44
    s_cmp_gt_u32 s59, 200000
    s_cbranch_scc1 L_qsum
    s_cmp_eq_u64 vcc, -1
    s_cbranch_scc1 L_qsum
    s_branch L_qpoll
L_qsum:
    v_add_f32 v60, v60, v62
    v_add_f32 v61, v61, v63
    v_add_f32 v64, v64, v66
    v_add_f32 v65, v65, v67
    v_add_f32 v60, v60, v64
    v_add_f32 v61, v61, v65
    v_cvt_pk_bf16_f32 v60, v60, v61
    v_mov_b32 v40, 1
    ds_write_b32 v95, v60 offset:512
    s_mov_b64 exec, 1
    ds_add_u32 v2, v40 offset:4
    s_mov_b64 exec, -1
    s_cmp_lg_u32 s56, 0
    s_cbranch_scc1 L_kdone
L_lw_2:
    ds_read_b32 v40, v2 offset:0
    s_waitcnt lgkmcnt(0)
    v_readfirstlane_b32 s52, v40
    s_cmp_ge_u32 s52, 2
    s_cbranch_scc1 L_lw_2_ok
    s_branch L_lw_2
L_lw_2_ok:
    s_mov_b32 s56, 1
    s_branch L_krd
L_kdone:
L_lw_3:
    ds_read_b32 v40, v2 offset:4
    s_waitcnt lgkmcnt(0)
    v_readfirstlane_b32 s52, v40
    s_cmp_ge_u32 s52, 4
    s_cbranch_scc1 L_lw_3_ok
    s_branch L_lw_3
L_lw_3_ok:
    ds_read_b128 v[128:131], v92 offset:512
    ds_read_b128 v[132:135], v92 offset:576
    ds_read_b128 v[136:139], v92 offset:640
    ds_read_b128 v[140:143], v92 offset:704
    ds_read_b128 v[144:147], v92 offset:768
    ds_read_b128 v[148:151], v92 offset:832
    ds_read_b128 v[152:155], v92 offset:896
    ds_read_b128 v[156:159], v92 offset:960
    s_waitcnt lgkmcnt(7)
    v_mfma_f32_16x16x32_bf16 v[76:79], v[96:99], v[128:131], 0
    s_waitcnt lgkmcnt(6)
    v_mfma_f32_16x16x32_bf16 v[76:79], v[100:103], v[132:135], v[76:79]
    s_waitcnt lgkmcnt(5)
    v_mfma_f32_16x16x32_bf16 v[76:79], v[104:107], v[136:139], v[76:79]
    s_waitcnt lgkmcnt(4)
    v_mfma_f32_16x16x32_bf16 v[76:79], v[108:111], v[140:143], v[76:79]
    s_waitcnt lgkmcnt(3)
    v_mfma_f32_16x16x32_bf16 v[76:79], v[112:115], v[144:147], v[76:79]
    s_waitcnt lgkmcnt(2)
    v_mfma_f32_16x16x32_bf16 v[76:79], v[116:119], v[148:151], v[76:79]
    s_waitcnt lgkmcnt(1)
    v_mfma_f32_16x16x32_bf16 v[76:79], v[120:123], v[152:155], v[76:79]
    s_waitcnt lgkmcnt(0)
    v_mfma_f32_16x16x32_bf16 v[76:79], v[124:127], v[156:159], v[76:79]
    s_mov_b32 s54, 0x00030003
    s_mov_b32 s55, 0x00030003
    v_mov_b32 v40, 1
    s_nop 5
    v_cvt_pk_bf16_f32 v46, v76, v77
    v_cvt_pk_bf16_f32 v47, v78, v79
    s_mov_b64 exec, s[54:55]
    ds_write_b64 v94, v[46:47] offset:128
    s_mov_b64 exec, 1
    ds_add_u32 v2, v40 offset:8
    s_mov_b64 exec, -1
L_lw_4:
    ds_read_b32 v40, v2 offset:8
    s_waitcnt lgkmcnt(0)
    v_readfirstlane_b32 s52, v40
    s_cmp_ge_u32 s52, 4
    s_cbranch_scc1 L_lw_4_ok
    s_branch L_lw_4
L_lw_4_ok:
    ds_read_b128 v[68:71], v93 offset:128
    ds_read_b128 v[72:75], v93 offset:192
    s_waitcnt lgkmcnt(0)
    v_lshlrev_b32 v96, 16, v68
    v_and_b32 v97, s63, v68
    v_lshlrev_b32 v98, 16, v69
    v_and_b32 v99, s63, v69
    v_lshlrev_b32 v100, 16, v70
    v_and_b32 v101, s63, v70
    v_lshlrev_b32 v102, 16, v71
    v_and_b32 v103, s63, v71
    v_lshlrev_b32 v104, 16, v72
    v_and_b32 v105, s63, v72
    v_lshlrev_b32 v106, 16, v73
    v_and_b32 v107, s63, v73
    v_lshlrev_b32 v108, 16, v74
    v_and_b32 v109, s63, v74
    v_lshlrev_b32 v110, 16, v75
    v_and_b32 v111, s63, v75
    v_max3_f32 v76, v96, v97, v98
    v_max3_f32 v77, v99, v100, v101
    v_max3_f32 v78, v102, v103, v104
    v_max3_f32 v79, v105, v106, v107
    v_max3_f32 v76, v76, v108, v109
    v_max3_f32 v77, v77, v110, v111
    v_max3_f32 v76, v76, v77, v78
    v_max_f32 v76, v76, v79
    v_mov_b32 v77, v76
    s_nop 1
    v_permlane16_swap_b32 v76, v77
    v_max_f32 v76, v76, v77
    v_mov_b32 v77, v76
    s_nop 1
    v_permlane32_swap_b32 v76, v77
    v_max_f32 v76, v76, v77
    v_mul_f32 v79, s65, v76
    v_fma_f32 v96, v96, s65, -v79
    v_exp_f32 v96, v96
    v_fma_f32 v97, v97, s65, -v79
    v_exp_f32 v97, v97
    v_fma_f32 v98, v98, s65, -v79
    v_exp_f32 v98, v98
    v_fma_f32 v99, v99, s65, -v79
    v_exp_f32 v99, v99
    v_fma_f32 v100, v100, s65, -v79
    v_exp_f32 v100, v100
    v_fma_f32 v101, v101, s65, -v79
    v_exp_f32 v101, v101
    v_fma_f32 v102, v102, s65, -v79
    v_exp_f32 v102, v102
    v_fma_f32 v103, v103, s65, -v79
    v_exp_f32 v103, v103
    v_fma_f32 v104, v104, s65, -v79
    v_exp_f32 v104, v104
    v_fma_f32 v105, v105, s65, -v79
    v_exp_f32 v105, v105
    v_fma_f32 v106, v106, s65, -v79
    v_exp_f32 v106, v106
    v_fma_f32 v107, v107, s65, -v79
    v_exp_f32 v107, v107
    v_fma_f32 v108, v108, s65, -v79
    v_exp_f32 v108, v108
    v_fma_f32 v109, v109, s65, -v79
    v_exp_f32 v109, v109
    v_fma_f32 v110, v110, s65, -v79
    v_exp_f32 v110, v110
    v_fma_f32 v111, v111, s65, -v79
    v_exp_f32 v111, v111
    s_nop 0
    v_cvt_pk_bf16_f32 v68, v96, v97
    v_cvt_pk_bf16_f32 v69, v98, v99
    v_cvt_pk_bf16_f32 v70, v100, v101
    v_cvt_pk_bf16_f32 v71, v102, v103
    v_cvt_pk_bf16_f32 v72, v104, v105
    v_cvt_pk_bf16_f32 v73, v106, v107
    v_cvt_pk_bf16_f32 v74, v108, v109
    v_cvt_pk_bf16_f32 v75, v110, v111
    v_and_b32 v128, v68, v160
    v_and_b32 v129, v69, v160
    v_and_b32 v130, v70, v160
    v_and_b32 v131, v71, v160
    v_and_b32 v132, v72, v160
    v_and_b32 v133, v73, v160
    v_and_b32 v134, v74, v160
    v_and_b32 v135, v75, v160
    v_and_b32 v136, v68, v161
    v_and_b32 v137, v69, v161
    v_and_b32 v138, v70, v161
    v_and_b32 v139, v71, v161
    v_and_b32 v140, v72, v161
    v_and_b32 v141, v73, v161
    v_and_b32 v142, v74, v161
    v_and_b32 v143, v75, v161
    v_and_b32 v144, v68, v162
    v_and_b32 v145, v69, v162
    v_and_b32 v146, v70, v162
    v_and_b32 v147, v71, v162
    v_and_b32 v148, v72, v162
    v_and_b32 v149, v73, v162
    v_and_b32 v150, v74, v162
    v_and_b32 v151, v75, v162
    v_and_b32 v152, v68, v163
    v_and_b32 v153, v69, v163
    v_and_b32 v154, v70, v163
    v_and_b32 v155, v71, v163
    v_and_b32 v156, v72, v163
    v_and_b32 v157, v73, v163
    v_and_b32 v158, v74, v163
    v_and_b32 v159, v75, v163
    s_cmp_lg_u32 s3, 0
    s_cbranch_scc1 L_noml
    v_add_f32 v77, v96, v97
    v_add_f32 v78, v98, v99
    v_add_f32 v77, v77, v100
    v_add_f32 v78, v78, v101
    v_add_f32 v77, v77, v102
    v_add_f32 v78, v78, v103
    v_add_f32 v77, v77, v104
    v_add_f32 v78, v78, v105
    v_add_f32 v77, v77, v106
    v_add_f32 v78, v78, v107
    v_add_f32 v77, v77, v108
    v_add_f32 v78, v78, v109
    v_add_f32 v77, v77, v110
    v_add_f32 v78, v78, v111
    v_add_f32 v77, v77, v78
    v_mov_b32 v78, v77
    s_nop 1
    v_permlane16_swap_b32 v77, v78
    v_add_f32 v77, v77, v78
    v_mov_b32 v78, v77
    s_nop 1
    v_permlane32_swap_b32 v77, v78
    v_add_f32 v77, v77, v78
    v_mov_b32 v78, s61
    v_mov_b32 v79, s7
    s_lshl_b32 s53, s4, 10
    s_lshl_b32 s54, s5, 4
    s_add_u32 s53, s53, s54
    s_add_u32 s53, s53, 106496
    v_lshlrev_b32 v86, 9, v0
    s_mov_b64 exec, 3
    buffer_store_dwordx4 v[76:79], v86, s[36:39], s53 offen
    s_add_u32 s53, s53, s60
    v_add_u32 v178, s53, v86
    s_mov_b64 exec, -1
    v_mov_b32 v174, v76
    v_mov_b32 v175, v77
    v_mov_b32 v176, v78
    v_mov_b32 v177, v79
L_noml:
    s_mov_b32 s54, 0x00ff00ff
    s_mov_b32 s55, 0x00ff00ff
L_lw_5:
    ds_read_b32 v40, v2 offset:0
    s_waitcnt lgkmcnt(0)
    v_readfirstlane_b32 s52, v40
    s_cmp_ge_u32 s52, 4
    s_cbranch_scc1 L_lw_5_ok
    s_branch L_lw_5
L_lw_5_ok:
    ds_read_b64_tr_b16 v[96:97], v81 offset:0
    ds_read_b64_tr_b16 v[98:99], v81 offset:8192
    ds_read_b64_tr_b16 v[100:101], v81 offset:16384
    ds_read_b64_tr_b16 v[102:103], v81 offset:24576
    ds_read_b64_tr_b16 v[104:105], v82 offset:0
    ds_read_b64_tr_b16 v[106:107], v82 offset:8192
    ds_read_b64_tr_b16 v[108:109], v82 offset:16384
    ds_read_b64_tr_b16 v[110:111], v82 offset:24576
    ds_read_b64_tr_b16 v[112:113], v83 offset:0
    ds_read_b64_tr_b16 v[114:115], v83 offset:8192
    ds_read_b64_tr_b16 v[116:117], v83 offset:16384
    ds_read_b64_tr_b16 v[118:119], v83 offset:24576
    ds_read_b64_tr_b16 v[120:121], v84 offset:0
    ds_read_b64_tr_b16 v[122:123], v84 offset:8192
    ds_read_b64_tr_b16 v[124:125], v84 offset:16384
    ds_read_b64_tr_b16 v[126:127], v84 offset:24576
    s_waitcnt lgkmcnt(14)
    v_mfma_f32_16x16x32_bf16 v[76:79], v[96:99], v[128:131], 0
    s_waitcnt lgkmcnt(12)
    v_mfma_f32_16x16x32_bf16 v[76:79], v[100:103], v[132:135], v[76:79]
    s_waitcnt lgkmcnt(10)
    v_mfma_f32_16x16x32_bf16 v[76:79], v[104:107], v[136:139], v[76:79]
    s_waitcnt lgkmcnt(8)
    v_mfma_f32_16x16x32_bf16 v[76:79], v[108:111], v[140:143], v[76:79]
    s_waitcnt lgkmcnt(6)
    v_mfma_f32_16x16x32_bf16 v[76:79], v[112:115], v[144:147], v[76:79]
    s_waitcnt lgkmcnt(4)
    v_mfma_f32_16x16x32_bf16 v[76:79], v[116:119], v[148:151], v[76:79]
    s_waitcnt lgkmcnt(2)
    v_mfma_f32_16x16x32_bf16 v[76:79], v[120:123], v[152:155], v[76:79]
    s_waitcnt lgkmcnt(0)
    v_mfma_f32_16x16x32_bf16 v[76:79], v[124:127], v[156:159], v[76:79]
    s_nop 7
    v_bfi_b32 v76, s62, v43, v76
    v_bfi_b32 v77, s62, v43, v77
    v_bfi_b32 v78, s62, v43, v78
    v_bfi_b32 v79, s62, v43, v79
    s_mov_b64 exec, s[54:55]
    buffer_store_dwordx4 v[76:79], v85, s[36:39], s58 offen
    s_add_u32 s58, s58, s60
    v_add_u32 v184, s58, v85
    s_mov_b64 exec, -1
    v_mov_b32 v180, v76
    v_mov_b32 v181, v77
    v_mov_b32 v182, v78
    v_mov_b32 v183, v79
    v_lshrrev_b32 v81, 1, v0
    v_lshlrev_b32 v86, 4, v81
    s_lshl_b32 s53, s4, 10
    s_lshr_b32 s54, s5, 4
    s_lshl_b32 s54, s54, 9
    s_add_u32 s53, s53, s54
    s_add_u32 s56, s53, 106496
    v_lshlrev_b32 v81, 6, v81
    v_and_b32 v82, 1, v0
    v_lshl_add_u32 v81, v82, 3, v81
    s_lshl_b32 s53, s4, 16
    s_lshl_b32 s54, s5, 11
    s_add_u32 s53, s53, s54
    s_lshl_b32 s54, s3, 4
    s_add_u32 s53, s53, s54
    s_add_u32 s57, s53, 131072
    v_min_u32 v80, 2, v9
    v_lshl_add_u32 v80, v80, 3, v11
    v_mul_u32_u24 v80, 896, v80
    v_lshl_add_u32 v80, v10, 3, v80
    s_mul_i32 s53, s3, 224
    v_add_u32 v80, s53, v80
    v_and_b32 v83, 1, v9
    v_lshl_add_u32 v83, v82, 1, v83
    v_lshlrev_b32 v83, 1, v83
    s_lshl_b32 s54, s3, 3
    v_add_u32 v83, s54, v83
    v_lshlrev_b32 v85, 14, v8
    v_lshl_add_u32 v85, v9, 4, v85
    s_mul_i32 s58, s3, 114688
    s_lshl_b32 s54, s2, 6
    s_add_u32 s58, s58, s54
    s_add_u32 s58, s58, 1048576
    v_cmp_eq_u32 vcc, 0, v8
    v_cmp_eq_u32 s[54:55], 1, v8
    s_nop 0
    v_cndmask_b32 v88, 0, -1, vcc
    v_cndmask_b32 v89, 0, -1, s[54:55]
    v_cmp_eq_u32 vcc, 2, v8
    v_cmp_eq_u32 s[54:55], 3, v8
    s_nop 0
    v_cndmask_b32 v90, 0, -1, vcc
    v_cndmask_b32 v91, 0, -1, s[54:55]
    v_cmp_eq_u32 vcc, 4, v8
    v_cmp_eq_u32 s[54:55], 5, v8
    s_nop 0
    v_cndmask_b32 v92, 0, -1, vcc
    v_cndmask_b32 v93, 0, -1, s[54:55]
    v_cmp_eq_u32 vcc, 6, v8
    s_nop 0
    s_nop 0
    v_cndmask_b32 v94, 0, -1, vcc
    s_mov_b32 s59, 0
    s_mov_b32 s55, 0
L_opoll:
    s_cmp_lt_u32 s59, 64
    s_cbranch_scc1 L_ont
    s_bitcmp1_b32 s6, 1
    s_cbranch_scc1 L_fl1t
    s_bitset1_b32 s6, 1
    buffer_store_dwordx4 v[168:171], v172, s[36:39], 0 offen sc1
    buffer_store_dwordx4 v[174:177], v178, s[36:39], 0 offen sc1
    buffer_store_dwordx4 v[180:183], v184, s[36:39], 0 offen sc1
L_fl1t:
L_ont:
    s_and_b32 s53, s59, 127
    s_cmp_eq_u32 s53, 127
    s_cselect_b32 s53, s60, 0
    s_add_u32 s54, s53, s56
    s_add_u32 s53, s53, s57
    buffer_load_dwordx4 v[64:67], v86, s[36:39], s54 offen sc1
    buffer_load_dwordx2 v[60:61], v81, s[36:39], s53 offen sc1
    s_cmp_lg_u32 s55, 0
    s_cbranch_scc1 L_owc
    ds_read_b32 v40, v2
    s_waitcnt lgkmcnt(0)
    v_readfirstlane_b32 s52, v40
    s_cmp_lt_u32 s52, 5
    s_cbranch_scc1 L_owc
L_wcrd:
    s_add_u32 s55, s55, 1
    ds_read_b64_tr_b16 v[96:97], v80 offset:24576
    ds_read_b64_tr_b16 v[98:99], v80 offset:28160
    ds_read_b64_tr_b16 v[100:101], v80 offset:24608
    ds_read_b64_tr_b16 v[102:103], v80 offset:28192
    ds_read_b64_tr_b16 v[104:105], v80 offset:24640
    ds_read_b64_tr_b16 v[106:107], v80 offset:28224
    ds_read_b64_tr_b16 v[108:109], v80 offset:24672
    ds_read_b64_tr_b16 v[110:111], v80 offset:28256
    ds_read_b64_tr_b16 v[112:113], v80 offset:24704
    ds_read_b64_tr_b16 v[114:115], v80 offset:28288
    ds_read_b64_tr_b16 v[116:117], v80 offset:24736
    ds_read_b64_tr_b16 v[118:119], v80 offset:28320
    ds_read_b64_tr_b16 v[120:121], v80 offset:24768
    ds_read_b64_tr_b16 v[122:123], v80 offset:28352
    s_cmp_gt_u32 s55, 1
    s_cbranch_scc1 L_wcdone
L_owc:
    s_waitcnt vmcnt(0)
    v_xor_b32 v60, v60, v43
    v_xor_b32 v61, v61, v43
    v_or_b32 v44, v60, v61
    v_and_b32 v44, s62, v44
    v_xor_b32 v45, s61, v66
    v_xor_b32 v46, s61, v67
    v_lshlrev_b32 v46, 8, v46
    v_or3_b32 v44, v44, v45, v46
    v_cmp_ne_u32 vcc, 0, v44
    s_add_u32 s59, s59, 1
    s_cmp_gt_u32 s59, 200000
    s_cbranch_scc1 L_opoll_ok
    s_cmp_lg_u64 vcc, 0
    s_cbranch_scc1 L_opoll
L_opoll_ok:
    v_cmp_ne_u32 vcc, s7, v67
    v_mov_b32 v62, v64
    s_cmp_eq_u64 vcc, 0
    s_cselect_b32 s68, 1, 2
    v_mov_b32 v40, s68
    ds_write_b32 v2, v40 offset:12
    s_nop 1
    v_max_f32_dpp v62, v62, v62 quad_perm:[1,0,3,2] row_mask:0xf bank_mask:0xf
    s_nop 1
    v_max_f32_dpp v62, v62, v62 quad_perm:[2,3,0,1] row_mask:0xf bank_mask:0xf
    s_nop 1
    v_max_f32_dpp v62, v62, v62 row_ror:4 row_mask:0xf bank_mask:0xf
    s_nop 1
    v_max_f32_dpp v62, v62, v62 row_ror:8 row_mask:0xf bank_mask:0xf
    v_mov_b32 v63, v62
    s_nop 1
    v_permlane16_swap_b32 v62, v63
    v_max_f32 v62, v62, v63
    v_mov_b32 v63, v62
    s_nop 1
    v_permlane32_swap_b32 v62, v63
    v_max_f32 v62, v62, v63
    v_sub_f32 v64, v64, v62
    v_mul_f32 v64, s65, v64
    v_exp_f32 v64, v64
    s_nop 0
    v_mul_f32 v60, v60, v64
    v_mul_f32 v61, v61, v64
    v_mul_f32 v65, v65, v64
    v_mov_b32 v66, v65
    s_nop 0
    v_permlane16_swap_b32 v60, v61
    v_permlane16_swap_b32 v65, v66
    v_add_f32 v60, v60, v61
    v_add_f32 v65, v65, v66
    v_mov_b32 v61, v60
    v_mov_b32 v66, v65
    s_nop 0
    v_permlane32_swap_b32 v60, v61
    v_permlane32_swap_b32 v65, v66
    v_add_f32 v60, v60, v61
    v_add_f32 v65, v65, v66
    s_nop 0
    v_add_f32_dpp v60, v60, v60 quad_perm:[2,3,0,1] row_mask:0xf bank_mask:0xf
    v_add_f32_dpp v65, v65, v65 quad_perm:[2,3,0,1] row_mask:0xf bank_mask:0xf
    s_nop 0
    v_add_f32_dpp v60, v60, v60 row_ror:4 row_mask:0xf bank_mask:0xf
    v_add_f32_dpp v65, v65, v65 row_ror:4 row_mask:0xf bank_mask:0xf
    s_nop 0
    v_add_f32_dpp v60, v60, v60 row_ror:8 row_mask:0xf bank_mask:0xf
    v_add_f32_dpp v65, v65, v65 row_ror:8 row_mask:0xf bank_mask:0xf
    v_rcp_f32 v66, v65
    s_mov_b32 s52, 0x00030003
    s_mov_b32 s53, 0
    v_mul_f32 v61, v60, v66
    v_fma_f32 v62, -v61, v65, v60
    v_fmac_f32 v61, v62, v66
    v_cvt_pk_bf16_f32 v60, v61, v61
    s_mov_b64 exec, s[52:53]
    ds_write_b16 v83, v60 offset:64
    s_mov_b64 exec, -1
    s_waitcnt lgkmcnt(0)
    s_barrier
    ds_read_b128 v[60:63], v87 offset:64
    s_cmp_lg_u32 s55, 0
    s_cbranch_scc1 L_wcdone
    s_mov_b32 s55, 1
    s_branch L_wcrd
L_wcdone:
    s_waitcnt lgkmcnt(0)
    v_and_b32 v128, v60, v88
    v_and_b32 v129, v61, v88
    v_and_b32 v130, v62, v88
    v_and_b32 v131, v63, v88
    v_and_b32 v132, v60, v89
    v_and_b32 v133, v61, v89
    v_and_b32 v134, v62, v89
    v_and_b32 v135, v63, v89
    v_mfma_f32_16x16x32_bf16 v[76:79], v[96:99], v[128:131], 0
    v_and_b32 v136, v60, v90
    v_and_b32 v137, v61, v90
    v_and_b32 v138, v62, v90
    v_and_b32 v139, v63, v90
    v_mfma_f32_16x16x32_bf16 v[76:79], v[100:103], v[132:135], v[76:79]
    v_and_b32 v140, v60, v91
    v_and_b32 v141, v61, v91
    v_and_b32 v142, v62, v91
    v_and_b32 v143, v63, v91
    v_mfma_f32_16x16x32_bf16 v[76:79], v[104:107], v[136:139], v[76:79]
    v_and_b32 v144, v60, v92
    v_and_b32 v145, v61, v92
    v_and_b32 v146, v62, v92
    v_and_b32 v147, v63, v92
    v_mfma_f32_16x16x32_bf16 v[76:79], v[108:111], v[140:143], v[76:79]
    v_and_b32 v148, v60, v93
    v_and_b32 v149, v61, v93
    v_and_b32 v150, v62, v93
    v_and_b32 v151, v63, v93
    v_mfma_f32_16x16x32_bf16 v[76:79], v[112:115], v[144:147], v[76:79]
    v_and_b32 v152, v60, v94
    v_and_b32 v153, v61, v94
    v_and_b32 v154, v62, v94
    v_and_b32 v155, v63, v94
    v_mfma_f32_16x16x32_bf16 v[76:79], v[116:119], v[148:151], v[76:79]
    s_nop 1
    v_mfma_f32_16x16x32_bf16 v[76:79], v[120:123], v[152:155], v[76:79]
    s_mov_b32 s54, 0x007f007f
    s_mov_b32 s55, 0x007f007f
    s_nop 5
    v_bfi_b32 v76, s62, v43, v76
    v_bfi_b32 v77, s62, v43, v77
    v_bfi_b32 v78, s62, v43, v78
    v_bfi_b32 v79, s62, v43, v79
    s_mov_b64 exec, s[54:55]
    buffer_store_dwordx4 v[76:79], v85, s[36:39], s58 offen sc1
    s_mov_b64 exec, -1
    s_cmp_eq_u32 s68, 1
    s_cbranch_scc1 L_fl1n
    s_bitcmp1_b32 s6, 1
    s_cbranch_scc1 L_fl1n
    s_bitset1_b32 s6, 1
    buffer_store_dwordx4 v[168:171], v172, s[36:39], 0 offen sc1
    buffer_store_dwordx4 v[174:177], v178, s[36:39], 0 offen sc1
    buffer_store_dwordx4 v[180:183], v184, s[36:39], 0 offen sc1
L_fl1n:
    s_branch L_end
L_aux:
    ds_write_b128 v16, v[4:7]
    s_lshr_b32 s68, s5, 2
    s_lshl_b32 s54, s4, 2
    s_add_u32 s68, s68, s54
    s_and_b32 s54, s5, 3
    s_lshl_b32 s69, s68, 2
    s_add_u32 s69, s69, s54
    v_lshlrev_b32 v20, 1, v9
    v_and_b32 v20, 2, v20
    v_lshrrev_b32 v21, 1, v9
    v_or_b32 v20, v20, v21
    v_lshlrev_b32 v20, 1, v20
    s_lshl_b32 s54, s69, 3
    buffer_load_ushort v21, v20, s[8:11], s54 offen
    buffer_load_ushort v22, v20, s[48:51], s54 offen
    s_and_b32 s60, s61, 0xff
    v_mov_b32 v43, s60
    s_lshr_b32 s60, s61, 8
    s_and_b32 s60, s60, 127
    s_lshl_b32 s60, s60, 20
    s_add_u32 s60, s60, 0x200000
    v_mov_b32 v104, 0x7ff00000
    v_mov_b32 v110, 0x7ff00000
    s_cmp_ge_u32 s5, 28
    s_cbranch_scc1 L_hchk
    s_mul_i32 s53, s4, 224
    s_lshl_b32 s54, s5, 3
    s_add_u32 s53, s53, s54
    s_lshl_b32 s53, s53, 1
    v_and_b32 v17, 1, v0
    v_lshlrev_b32 v17, 3, v17
    buffer_load_dwordx2 v[18:19], v17, s[44:47], s53 offen
    s_and_b32 s53, s5, 3
    s_mul_i32 s53, s53, 224
    s_add_u32 s53, s53, s7
    v_lshl_add_u32 v41, v9, 3, s53
    ds_read2_b64 v[44:47], v41 offset0:0 offset1:4
    ds_read2_b64 v[48:51], v41 offset0:8 offset1:12
    ds_read2_b64 v[52:55], v41 offset0:16 offset1:20
    ds_read_b64 v[56:57], v41 offset:192
    v_lshlrev_b32 v15, 6, v13
    v_and_b32 v42, 1, v9
    v_lshl_add_u32 v15, v42, 5, v15
    v_lshl_add_u32 v42, v10, 3, v15
    s_lshl_b32 s57, s4, 12
    s_and_b32 s53, s5, 3
    s_lshl_b32 s53, s53, 10
    s_add_u32 s57, s57, s53
    s_lshr_b32 s53, s5, 2
    s_lshl_b32 s53, s53, 7
    s_add_u32 s57, s57, s53
    s_add_u32 s57, s57, 73728
    s_add_u32 s56, s57, s60
    s_mov_b32 s54, 0x00010001
    s_mov_b32 s55, 0x00010001
L_lw_6:
    ds_read_b32 v40, v2 offset:0
    s_waitcnt lgkmcnt(0)
    v_readfirstlane_b32 s52, v40
    s_cmp_ge_u32 s52, 3
    s_cbranch_scc1 L_lw_6_ok
    s_sleep 1
    s_branch L_lw_6
L_lw_6_ok:
    ds_read_b64_tr_b16 v[60:61], v42 offset:46080
    ds_read_b64_tr_b16 v[62:63], v42 offset:47104
    ds_read_b64_tr_b16 v[64:65], v42 offset:48128
    ds_read_b64_tr_b16 v[66:67], v42 offset:49152
    ds_read_b64_tr_b16 v[68:69], v42 offset:50176
    ds_read_b64_tr_b16 v[70:71], v42 offset:51200
    ds_read_b64_tr_b16 v[72:73], v42 offset:52224
    s_waitcnt lgkmcnt(5)
    v_mfma_f32_16x16x32_bf16 v[100:103], v[60:63], v[44:47], 0
    s_waitcnt lgkmcnt(3)
    v_mfma_f32_16x16x32_bf16 v[100:103], v[64:67], v[48:51], v[100:103]
    s_waitcnt lgkmcnt(1)
    v_mfma_f32_16x16x32_bf16 v[100:103], v[68:71], v[52:55], v[100:103]
    s_waitcnt lgkmcnt(0)
    v_mfma_f32_16x16x32_bf16 v[100:103], v[72:75], v[56:59], v[100:103]
    s_nop 7
    v_add_u32 v100, 0x80, v100
    v_add_u32 v101, 0x80, v101
    v_add_u32 v102, 0x80, v102
    v_add_u32 v103, 0x80, v103
    v_bfi_b32 v100, s62, v43, v100
    v_bfi_b32 v101, s62, v43, v101
    v_bfi_b32 v102, s62, v43, v102
    v_bfi_b32 v103, s62, v43, v103
    s_mov_b64 exec, s[54:55]
    buffer_store_dwordx4 v[100:103], v87, s[36:39], s57 offen
    v_add_u32 v104, s56, v87
    s_mov_b64 exec, -1
    v_xor_b32 v42, 32, v42
    s_add_u32 s57, s57, 64
    s_add_u32 s56, s56, 64
    ds_read_b64_tr_b16 v[60:61], v42 offset:46080
    ds_read_b64_tr_b16 v[62:63], v42 offset:47104
    ds_read_b64_tr_b16 v[64:65], v42 offset:48128
    ds_read_b64_tr_b16 v[66:67], v42 offset:49152
    ds_read_b64_tr_b16 v[68:69], v42 offset:50176
    ds_read_b64_tr_b16 v[70:71], v42 offset:51200
    ds_read_b64_tr_b16 v[72:73], v42 offset:52224
    s_waitcnt lgkmcnt(5)
    v_mfma_f32_16x16x32_bf16 v[106:109], v[60:63], v[44:47], 0
    s_waitcnt lgkmcnt(3)
    v_mfma_f32_16x16x32_bf16 v[106:109], v[64:67], v[48:51], v[106:109]
    s_waitcnt lgkmcnt(1)
    v_mfma_f32_16x16x32_bf16 v[106:109], v[68:71], v[52:55], v[106:109]
    s_waitcnt lgkmcnt(0)
    v_mfma_f32_16x16x32_bf16 v[106:109], v[72:75], v[56:59], v[106:109]
    s_nop 7
    v_add_u32 v106, 0x80, v106
    v_add_u32 v107, 0x80, v107
    v_add_u32 v108, 0x80, v108
    v_add_u32 v109, 0x80, v109
    v_bfi_b32 v106, s62, v43, v106
    v_bfi_b32 v107, s62, v43, v107
    v_bfi_b32 v108, s62, v43, v108
    v_bfi_b32 v109, s62, v43, v109
    s_mov_b64 exec, s[54:55]
    buffer_store_dwordx4 v[106:109], v87, s[36:39], s57 offen
    v_add_u32 v110, s56, v87
    s_mov_b64 exec, -1
    v_xor_b32 v42, 32, v42
    s_add_u32 s57, s57, 64
    s_add_u32 s56, s56, 64
L_hchk:
    v_mov_b32 v68, 0
    v_mov_b32 v69, 0
    s_cmp_ge_u32 s5, 28
    s_cbranch_scc1 L_hw
    v_bfe_u32 v48, v0, 1, 2
    v_lshlrev_b32 v48, 10, v48
    v_and_b32 v49, 1, v0
    v_lshl_add_u32 v48, v49, 4, v48
    s_lshl_b32 s53, s4, 12
    s_lshl_b32 s54, s5, 5
    s_add_u32 s53, s53, s54
    s_add_u32 s57, s53, 73728
    s_mov_b32 s59, 0
L_hpoll:
    s_cmp_lg_u32 s59, 30
    s_cbranch_scc1 L_hnt
    buffer_store_dwordx4 v[100:103], v104, s[36:39], 0 offen sc1
    buffer_store_dwordx4 v[106:109], v110, s[36:39], 0 offen sc1
L_hnt:
    s_sleep 4
    s_and_b32 s53, s59, 31
    s_cmp_eq_u32 s53, 31
    s_cselect_b32 s53, s60, 0
    s_add_u32 s53, s53, s57
    buffer_load_dwordx4 v[60:63], v48, s[36:39], s53 offen sc1
    s_waitcnt vmcnt(0)
    v_xor_b32 v60, v60, v43
    v_xor_b32 v61, v61, v43
    v_xor_b32 v62, v62, v43
    v_xor_b32 v63, v63, v43
    v_or3_b32 v44, v60, v61, v62
    v_or_b32 v44, v44, v63
    v_and_b32 v44, s62, v44
    v_cmp_ne_u32 vcc, 0, v44
    s_add_u32 s59, s59, 1
    s_cmp_gt_u32 s59, 200000
    s_cbranch_scc1 L_hpoll_ok
    s_cmp_lg_u64 vcc, 0
    s_cbranch_scc1 L_hpoll
L_hpoll_ok:
    v_add_f32_dpp v60, v60, v60 quad_perm:[2,3,0,1] row_mask:0xf bank_mask:0xf
    v_add_f32_dpp v61, v61, v61 quad_perm:[2,3,0,1] row_mask:0xf bank_mask:0xf
    v_add_f32_dpp v62, v62, v62 quad_perm:[2,3,0,1] row_mask:0xf bank_mask:0xf
    v_add_f32_dpp v63, v63, v63 quad_perm:[2,3,0,1] row_mask:0xf bank_mask:0xf
    s_nop 0
    v_add_f32_dpp v60, v60, v60 row_ror:4 row_mask:0xf bank_mask:0xf
    v_add_f32_dpp v61, v61, v61 row_ror:4 row_mask:0xf bank_mask:0xf
    v_add_f32_dpp v62, v62, v62 row_ror:4 row_mask:0xf bank_mask:0xf
    v_add_f32_dpp v63, v63, v63 row_ror:4 row_mask:0xf bank_mask:0xf
    v_cvt_pk_bf16_f32 v64, v60, v61
    v_cvt_pk_bf16_f32 v65, v62, v63
    v_lshlrev_b32 v60, 16, v64
    v_and_b32 v61, s63, v64
    v_lshlrev_b32 v62, 16, v65
    v_and_b32 v63, s63, v65
    v_lshlrev_b32 v64, 16, v18
    v_and_b32 v65, s63, v18
    v_lshlrev_b32 v66, 16, v19
    v_and_b32 v67, s63, v19
    v_add_f32 v60, v60, v64
    v_add_f32 v61, v61, v65
    v_add_f32 v62, v62, v66
    v_add_f32 v63, v63, v67
    v_cvt_pk_bf16_f32 v64, v60, v61
    v_cvt_pk_bf16_f32 v65, v62, v63
    v_lshlrev_b32 v60, 16, v64
    v_and_b32 v61, s63, v64
    v_lshlrev_b32 v62, 16, v65
    v_and_b32 v63, s63, v65
    s_mov_b32 s53, 1027024659
    s_mov_b32 s54, 3222493025
    v_mul_f32 v64, v60, v60
    v_mul_f32 v64, s53, v64
    v_fma_f32 v64, v64, v60, v60
    v_mul_f32 v64, s54, v64
    v_exp_f32 v64, v64
    s_nop 0
    v_add_f32 v64, 1.0, v64
    v_rcp_f32 v64, v64
    s_nop 0
    v_mul_f32 v60, v60, v64
    v_mul_f32 v65, v61, v61
    v_mul_f32 v65, s53, v65
    v_fma_f32 v65, v65, v61, v61
    v_mul_f32 v65, s54, v65
    v_exp_f32 v65, v65
    s_nop 0
    v_add_f32 v65, 1.0, v65
    v_rcp_f32 v65, v65
    s_nop 0
    v_mul_f32 v61, v61, v65
    v_mul_f32 v66, v62, v62
    v_mul_f32 v66, s53, v66
    v_fma_f32 v66, v66, v62, v62
    v_mul_f32 v66, s54, v66
    v_exp_f32 v66, v66
    s_nop 0
    v_add_f32 v66, 1.0, v66
    v_rcp_f32 v66, v66
    s_nop 0
    v_mul_f32 v62, v62, v66
    v_mul_f32 v67, v63, v63
    v_mul_f32 v67, s53, v67
    v_fma_f32 v67, v67, v63, v63
    v_mul_f32 v67, s54, v67
    v_exp_f32 v67, v67
    s_nop 0
    v_add_f32 v67, 1.0, v67
    v_rcp_f32 v67, v67
    s_nop 0
    v_mul_f32 v63, v63, v67
    v_cvt_pk_bf16_f32 v68, v60, v61
    v_cvt_pk_bf16_f32 v69, v62, v63
    v_cmp_gt_u32 vcc, 2, v0
    s_nop 1
    v_cndmask_b32 v68, 0, v68, vcc
    v_cndmask_b32 v69, 0, v69, vcc
L_hw:
    v_lshlrev_b32 v48, 3, v0
    s_mov_b64 exec, 15
    ds_write_b64 v48, v[68:69] offset:96
    s_mov_b64 exec, -1
    s_lshl_b32 s53, s68, 14
    s_and_b32 s54, s5, 3
    s_lshl_b32 s54, s54, 4
    s_add_u32 s53, s53, s54
    s_add_u32 s53, s53, 1048576
    s_add_u32 s54, s53, 4096
    s_add_u32 s55, s53, 8192
    s_add_u32 s56, s53, 12288
    v_lshlrev_b32 v80, 6, v0
    s_mov_b32 s59, 0
    s_waitcnt vmcnt(0) lgkmcnt(0)
    v_lshlrev_b32 v21, 16, v21
    v_lshlrev_b32 v22, 16, v22
    v_add_f32 v21, v21, v22
    s_barrier
    ds_read_b32 v40, v2 offset:12
    s_waitcnt lgkmcnt(0)
    v_readfirstlane_b32 s52, v40
    s_cmp_eq_u32 s52, 1
    s_cbranch_scc1 L_hnb
    buffer_store_dwordx4 v[100:103], v104, s[36:39], 0 offen sc1
    buffer_store_dwordx4 v[106:109], v110, s[36:39], 0 offen sc1
L_hnb:
    s_cmp_ge_u32 s5, 16
    s_cbranch_scc1 L_end
    s_cmp_ge_u32 s68, 28
    s_cbranch_scc1 L_end
    s_mov_b32 s52, s56
    s_mov_b64 s[56:57], -1
    s_mov_b64 s[58:59], -1
    s_mov_b64 s[64:65], -1
    s_mov_b64 s[66:67], -1
    s_mov_b32 s63, 0
    s_sleep 20
L_ppoll:
    s_mov_b64 exec, s[56:57]
    s_cbranch_execz L_psk0
    buffer_load_dwordx4 v[128:131], v80, s[36:39], s53 offen sc1
L_psk0:
    s_mov_b64 exec, s[58:59]
    s_cbranch_execz L_psk1
    buffer_load_dwordx4 v[132:135], v80, s[36:39], s54 offen sc1
L_psk1:
    s_mov_b64 exec, s[64:65]
    s_cbranch_execz L_psk2
    buffer_load_dwordx4 v[136:139], v80, s[36:39], s55 offen sc1
L_psk2:
    s_mov_b64 exec, s[66:67]
    s_cbranch_execz L_psk3
    buffer_load_dwordx4 v[140:143], v80, s[36:39], s52 offen sc1
L_psk3:
    s_mov_b64 exec, -1
    s_waitcnt vmcnt(0)
    v_xor_b32 v144, v128, v43
    v_xor_b32 v145, v129, v43
    v_xor_b32 v146, v130, v43
    v_xor_b32 v147, v131, v43
    v_or3_b32 v44, v144, v145, v146
    v_or_b32 v44, v44, v147
    v_and_b32 v44, s62, v44
    v_cmp_ne_u32 s[56:57], 0, v44
    v_xor_b32 v148, v132, v43
    v_xor_b32 v149, v133, v43
    v_xor_b32 v150, v134, v43
    v_xor_b32 v151, v135, v43
    v_or3_b32 v44, v148, v149, v150
    v_or_b32 v44, v44, v151
    v_and_b32 v44, s62, v44
    v_cmp_ne_u32 s[58:59], 0, v44
    v_xor_b32 v152, v136, v43
    v_xor_b32 v153, v137, v43
    v_xor_b32 v154, v138, v43
    v_xor_b32 v155, v139, v43
    v_or3_b32 v44, v152, v153, v154
    v_or_b32 v44, v44, v155
    v_and_b32 v44, s62, v44
    v_cmp_ne_u32 s[64:65], 0, v44
    v_xor_b32 v156, v140, v43
    v_xor_b32 v157, v141, v43
    v_xor_b32 v158, v142, v43
    v_xor_b32 v159, v143, v43
    v_or3_b32 v44, v156, v157, v158
    v_or_b32 v44, v44, v159
    v_and_b32 v44, s62, v44
    v_cmp_ne_u32 s[66:67], 0, v44
    s_add_u32 s63, s63, 1
    s_or_b64 s[6:7], s[56:57], s[58:59]
    s_or_b64 s[6:7], s[6:7], s[64:65]
    s_cmp_gt_u32 s63, 200000
    s_cbranch_scc1 L_psum
    s_or_b64 s[6:7], s[6:7], s[66:67]
    s_cbranch_scc1 L_ppoll
L_psum:
    v_add_f32 v60, v144, v148
    v_add_f32 v68, v152, v156
    v_add_f32 v61, v145, v149
    v_add_f32 v69, v153, v157
    v_add_f32 v62, v146, v150
    v_add_f32 v70, v154, v158
    v_add_f32 v63, v147, v151
    v_add_f32 v71, v155, v159
    v_add_f32 v60, v60, v68
    v_add_f32 v61, v61, v69
    v_add_f32 v62, v62, v70
    v_add_f32 v63, v63, v71
    s_nop 1
    v_permlane32_swap_b32 v60, v61
    v_permlane32_swap_b32 v62, v63
    v_add_f32 v60, v60, v61
    v_add_f32 v62, v62, v63
    s_nop 1
    v_permlane16_swap_b32 v60, v62
    v_add_f32 v60, v60, v62
    s_nop 1
    v_add_f32_dpp v60, v60, v60 quad_perm:[1,0,3,2] row_mask:0xf bank_mask:0xf
    s_nop 1
    v_add_f32_dpp v60, v60, v60 quad_perm:[2,3,0,1] row_mask:0xf bank_mask:0xf
    s_nop 1
    v_add_f32_dpp v60, v60, v60 row_ror:4 row_mask:0xf bank_mask:0xf
    s_nop 1
    v_add_f32_dpp v60, v60, v60 row_ror:8 row_mask:0xf bank_mask:0xf
    v_add_f32 v60, v60, v21
    v_cvt_pk_bf16_f32 v60, v60, v60
    s_mov_b32 s54, 0x00010001
    s_mov_b32 s55, 0x00010001
    s_lshl_b32 s53, s69, 3
    s_mov_b64 exec, s[54:55]
    buffer_store_short v60, v20, s[40:43], s53 offen
    s_mov_b64 exec, -1
    s_cmp_lg_u32 s2, 0
    s_cbranch_scc1 L_end
    v_mov_b32 v60, s61
    v_mov_b32 v61, 0
    s_mov_b64 exec, 1
    buffer_store_dword v60, v61, s[36:39], 0 offen
    s_mov_b64 exec, -1
L_end:
    s_endpgm

.section .rodata,"a"
.p2align 6
.amdhsa_kernel parallel_sum__sliding_block_cached__mixer_channel_mlp__decode_kernel
  .amdhsa_next_free_vgpr 208
  .amdhsa_next_free_sgpr 102
  .amdhsa_accum_offset 208
  .amdhsa_group_segment_fixed_size 0
  .amdhsa_kernarg_size 104
  .amdhsa_user_sgpr_count 2
  .amdhsa_user_sgpr_kernarg_segment_ptr 1
  .amdhsa_system_sgpr_workgroup_id_x 1
.end_amdhsa_kernel
```
